```python
import torch

def _softmax(x, axis=-1):
    return torch.softmax(x, dim=axis)
def _gelu(x):
    return torch.nn.functional.gelu(x, approximate="tanh")
def _silu(x):
    return torch.nn.functional.silu(x)
def _sigmoid(x):
    return torch.sigmoid(x)
def _layernorm(x, axis=-1, eps=1e-5):
    m = x.mean(dim=axis, keepdim=True)
    v = x.var(dim=axis, keepdim=True, unbiased=False)
    return (x - m) / torch.sqrt(v + eps)
def _scatter_add(tgt, idx, src, axis=0):
    return tgt.clone().index_add_(axis, idx, src)
def _segment_sum(src, seg, n):
    out = torch.zeros((n,) + src.shape[1:], dtype=src.dtype)
    return out.index_add_(0, seg, src)
def _pad(x, pw):
    flat = tuple(v for pair in reversed(pw) for v in pair)
    return torch.nn.functional.pad(x, flat)

kernel_name = 'standalone__channel_attn_cbam__vision'

def setup_inputs():

    _w = (lambda a: (lambda t: t.to(torch.bfloat16) if t.is_floating_point() else t)(torch.as_tensor(a)))
    H = W = 224
    C = 192
    r = max(C // 4, 1)
    return {
        "x": _w((lambda *s: torch.randn(*s, dtype=torch.bfloat16) * 0.2)(1, H, W, C) + (lambda *s: torch.randn(*s, dtype=torch.bfloat16) * 0.2)(1, 1, 1, C) * 2.0),
        "w1": _w((lambda *s: torch.randn(*s, dtype=torch.bfloat16) * 0.2)(C, r)),
        "w2": _w((lambda *s: torch.randn(*s, dtype=torch.bfloat16) * 0.2)(r, C)),
    }

def reference(x, w1, w2):
    B, H, W, C = x.shape
    xf = x.reshape(B, H * W, C)
    gap = torch.mean(xf, 1)
    gmp = torch.amax(xf, 1)
    h_a = gap @ w1
    h_a = h_a * (lambda x, dt: x.to(dt))(h_a > 0, h_a.dtype)
    h_m = gmp @ w1
    h_m = h_m * (lambda x, dt: x.to(dt))(h_m > 0, h_m.dtype)
    scale = _sigmoid(h_a @ w2 + h_m @ w2)
    return x * scale[:, None, None, :]
```

```asm
; @launch grid=(256,1,1) block=(192,1,1) lds=38400
.amdgcn_target "amdgcn-amd-amdhsa--gfx950"
.text
.globl standalone__channel_attn_cbam__vision_kernel
.p2align 12
.fill 704, 4, 0xbf810000
.p2align 8
.type standalone__channel_attn_cbam__vision_kernel,@function
standalone__channel_attn_cbam__vision_kernel:
    s_load_dwordx8 s[4:11], s[0:1], 0
    s_load_dwordx2 s[40:41], s[0:1], 40
    s_cmp_ge_u32 s2, 256
    s_cbranch_scc1 L_end
    v_lshrrev_b32 v1, 6, v0
    v_and_b32 v0, 63, v0
    v_readfirstlane_b32 s16, v1
    s_cmp_ge_u32 s2, 32
    s_cbranch_scc1 L_nocpf
    s_getpc_b64 s[44:45]
L_pc:
    v_lshlrev_b32 v5, 7, v0
    v_min_u32 v6, L_codeend-L_pc-4, v5
    v_mov_b32 v9, s45
    v_add_co_u32 v8, vcc, s44, v6
    v_addc_co_u32 v9, vcc, 0, v9, vcc
    global_load_dword v44, v[8:9], off
    v_add_u32 v6, 8192, v5
    v_min_u32 v6, L_codeend-L_pc-4, v6
    v_mov_b32 v9, s45
    v_add_co_u32 v8, vcc, s44, v6
    v_addc_co_u32 v9, vcc, 0, v9, vcc
    global_load_dword v45, v[8:9], off
L_nocpf:
    s_and_b32 s12, s2, 7
    s_lshr_b32 s13, s2, 3
    s_mov_b32 s38, 18432
    s_mov_b32 s39, 0x20000
    s_mov_b32 s42, 0x200000
    s_mov_b32 s43, 0x20000
    v_and_b32 v3, 7, v0
    v_lshlrev_b32 v4, 4, v0
    s_cmp_lt_u32 s2, 32
    s_cbranch_scc1 L_helper
    s_sub_u32 s13, s13, 4
    s_mul_i32 s3, s12, 28
    s_add_u32 s3, s3, s13
    s_mul_i32 s3, s3, 86016
    v_lshrrev_b32 v2, 3, v0
    s_lshl_b32 s19, s16, 7
    v_mul_u32_u24 v2, 384, v2
    v_lshl_add_u32 v2, v3, 4, v2
    v_add_u32 v1, s19, v2
    s_mov_b32 s22, 86016
    s_mov_b32 s23, 0x20000
    s_waitcnt lgkmcnt(0)
    s_add_u32 s20, s4, s3
    s_addc_u32 s21, s5, 0
    buffer_load_dwordx4 v[48:51], v1, s[20:23], 0 offen offset:0 nt
    buffer_load_dwordx4 v[52:55], v1, s[20:23], 0 offen offset:3072 nt
    s_load_dword s34, s[40:41], 0
    s_mov_b32 s30, 6144
    buffer_load_dwordx4 v[56:59], v1, s[20:23], s30 offen offset:0 nt
    buffer_load_dwordx4 v[60:63], v1, s[20:23], s30 offen offset:3072 nt
    s_mov_b32 s30, 12288
    buffer_load_dwordx4 v[64:67], v1, s[20:23], s30 offen offset:0 nt
    buffer_load_dwordx4 v[68:71], v1, s[20:23], s30 offen offset:3072 nt
    s_mov_b32 s30, 18432
    buffer_load_dwordx4 v[72:75], v1, s[20:23], s30 offen offset:0 nt
    buffer_load_dwordx4 v[76:79], v1, s[20:23], s30 offen offset:3072 nt
    s_mov_b32 s30, 24576
    buffer_load_dwordx4 v[80:83], v1, s[20:23], s30 offen offset:0 nt
    buffer_load_dwordx4 v[84:87], v1, s[20:23], s30 offen offset:3072 nt
    s_mov_b32 s30, 30720
    buffer_load_dwordx4 v[88:91], v1, s[20:23], s30 offen offset:0 nt
    buffer_load_dwordx4 v[92:95], v1, s[20:23], s30 offen offset:3072 nt
    s_mov_b32 s30, 36864
    buffer_load_dwordx4 v[96:99], v1, s[20:23], s30 offen offset:0 nt
    buffer_load_dwordx4 v[100:103], v1, s[20:23], s30 offen offset:3072 nt
    s_mov_b32 s30, 43008
    buffer_load_dwordx4 v[104:107], v1, s[20:23], s30 offen offset:0 nt
    buffer_load_dwordx4 v[108:111], v1, s[20:23], s30 offen offset:3072 nt
    s_mov_b32 s30, 49152
    buffer_load_dwordx4 v[112:115], v1, s[20:23], s30 offen offset:0 nt
    buffer_load_dwordx4 v[116:119], v1, s[20:23], s30 offen offset:3072 nt
    s_mov_b32 s30, 55296
    buffer_load_dwordx4 v[120:123], v1, s[20:23], s30 offen offset:0 nt
    buffer_load_dwordx4 v[124:127], v1, s[20:23], s30 offen offset:3072 nt
    s_mov_b32 s30, 61440
    buffer_load_dwordx4 v[128:131], v1, s[20:23], s30 offen offset:0 nt
    buffer_load_dwordx4 v[132:135], v1, s[20:23], s30 offen offset:3072 nt
    s_mov_b32 s30, 67584
    buffer_load_dwordx4 v[136:139], v1, s[20:23], s30 offen offset:0 nt
    buffer_load_dwordx4 v[140:143], v1, s[20:23], s30 offen offset:3072 nt
    s_mov_b32 s30, 73728
    buffer_load_dwordx4 v[144:147], v1, s[20:23], s30 offen offset:0 nt
    buffer_load_dwordx4 v[148:151], v1, s[20:23], s30 offen offset:3072 nt
    s_mov_b32 s30, 79872
    buffer_load_dwordx4 v[152:155], v1, s[20:23], s30 offen offset:0 nt
    buffer_load_dwordx4 v[156:159], v1, s[20:23], s30 offen offset:3072 nt
    s_add_u32 s24, s10, s3
    s_addc_u32 s25, s11, 0
    s_mov_b32 s26, 86016
    s_mov_b32 s27, 0x20000
    v_and_b32 v5, 1, v0
    v_lshlrev_b32 v5, 4, v5
    v_mov_b32 v6, 0x3f80
    v_lshlrev_b32 v5, v5, v6
    v_bfe_u32 v6, v0, 2, 2
    v_cmp_eq_u32 vcc, 0, v6
    s_nop 1
    v_cndmask_b32 v8, 0, v5, vcc
    v_cmp_eq_u32 vcc, 1, v6
    s_nop 1
    v_cndmask_b32 v9, 0, v5, vcc
    v_cmp_eq_u32 vcc, 2, v6
    s_nop 1
    v_cndmask_b32 v10, 0, v5, vcc
    v_cmp_eq_u32 vcc, 3, v6
    s_nop 1
    v_cndmask_b32 v11, 0, v5, vcc
    v_lshrrev_b32 v6, 4, v0
    v_lshlrev_b32 v40, 12, v6
    v_lshl_add_u32 v40, v3, 4, v40
    s_mul_i32 s35, s12, 12
    s_lshl_b32 s30, s16, 2
    s_add_u32 s35, s35, s30
    s_lshl_b32 s35, s35, 5
    s_add_u32 s35, s35, s13
    s_lshl_b32 s35, s35, 7
    s_add_u32 s35, s35, 4096
    s_mul_i32 s32, s16, 6144
    s_mov_b32 s33, 0x7fff7fff
    s_waitcnt lgkmcnt(0)
    s_mul_i32 s34, s34, 1664525
    s_add_u32 s34, s34, 1013904223
    s_waitcnt vmcnt(27)
    v_mfma_f32_16x16x32_bf16 v[12:15], v[8:11], v[48:51], 0
    s_waitcnt vmcnt(26)
    v_mfma_f32_16x16x32_bf16 v[12:15], v[8:11], v[52:55], v[12:15]
    v_pk_max_i16 v16, v48, v52
    v_pk_min_u16 v20, v48, v52
    v_pk_max_i16 v17, v49, v53
    v_pk_min_u16 v21, v49, v53
    v_pk_max_i16 v18, v50, v54
    v_pk_min_u16 v22, v50, v54
    v_pk_max_i16 v19, v51, v55
    v_pk_min_u16 v23, v51, v55
    s_waitcnt vmcnt(25)
    v_mfma_f32_16x16x32_bf16 v[12:15], v[8:11], v[56:59], v[12:15]
    v_pk_max_i16 v16, v16, v56
    v_pk_min_u16 v20, v20, v56
    v_pk_max_i16 v17, v17, v57
    v_pk_min_u16 v21, v21, v57
    v_pk_max_i16 v18, v18, v58
    v_pk_min_u16 v22, v22, v58
    v_pk_max_i16 v19, v19, v59
    v_pk_min_u16 v23, v23, v59
    s_waitcnt vmcnt(24)
    v_mfma_f32_16x16x32_bf16 v[12:15], v[8:11], v[60:63], v[12:15]
    v_pk_max_i16 v16, v16, v60
    v_pk_min_u16 v20, v20, v60
    v_pk_max_i16 v17, v17, v61
    v_pk_min_u16 v21, v21, v61
    v_pk_max_i16 v18, v18, v62
    v_pk_min_u16 v22, v22, v62
    v_pk_max_i16 v19, v19, v63
    v_pk_min_u16 v23, v23, v63
    s_waitcnt vmcnt(23)
    v_mfma_f32_16x16x32_bf16 v[12:15], v[8:11], v[64:67], v[12:15]
    v_pk_max_i16 v16, v16, v64
    v_pk_min_u16 v20, v20, v64
    v_pk_max_i16 v17, v17, v65
    v_pk_min_u16 v21, v21, v65
    v_pk_max_i16 v18, v18, v66
    v_pk_min_u16 v22, v22, v66
    v_pk_max_i16 v19, v19, v67
    v_pk_min_u16 v23, v23, v67
    s_waitcnt vmcnt(22)
    v_mfma_f32_16x16x32_bf16 v[12:15], v[8:11], v[68:71], v[12:15]
    v_pk_max_i16 v16, v16, v68
    v_pk_min_u16 v20, v20, v68
    v_pk_max_i16 v17, v17, v69
    v_pk_min_u16 v21, v21, v69
    v_pk_max_i16 v18, v18, v70
    v_pk_min_u16 v22, v22, v70
    v_pk_max_i16 v19, v19, v71
    v_pk_min_u16 v23, v23, v71
    s_waitcnt vmcnt(21)
    v_mfma_f32_16x16x32_bf16 v[12:15], v[8:11], v[72:75], v[12:15]
    v_pk_max_i16 v16, v16, v72
    v_pk_min_u16 v20, v20, v72
    v_pk_max_i16 v17, v17, v73
    v_pk_min_u16 v21, v21, v73
    v_pk_max_i16 v18, v18, v74
    v_pk_min_u16 v22, v22, v74
    v_pk_max_i16 v19, v19, v75
    v_pk_min_u16 v23, v23, v75
    s_waitcnt vmcnt(20)
    v_mfma_f32_16x16x32_bf16 v[12:15], v[8:11], v[76:79], v[12:15]
    v_pk_max_i16 v16, v16, v76
    v_pk_min_u16 v20, v20, v76
    v_pk_max_i16 v17, v17, v77
    v_pk_min_u16 v21, v21, v77
    v_pk_max_i16 v18, v18, v78
    v_pk_min_u16 v22, v22, v78
    v_pk_max_i16 v19, v19, v79
    v_pk_min_u16 v23, v23, v79
    s_waitcnt vmcnt(19)
    v_mfma_f32_16x16x32_bf16 v[12:15], v[8:11], v[80:83], v[12:15]
    v_pk_max_i16 v16, v16, v80
    v_pk_min_u16 v20, v20, v80
    v_pk_max_i16 v17, v17, v81
    v_pk_min_u16 v21, v21, v81
    v_pk_max_i16 v18, v18, v82
    v_pk_min_u16 v22, v22, v82
    v_pk_max_i16 v19, v19, v83
    v_pk_min_u16 v23, v23, v83
    s_waitcnt vmcnt(18)
    v_mfma_f32_16x16x32_bf16 v[12:15], v[8:11], v[84:87], v[12:15]
    v_pk_max_i16 v16, v16, v84
    v_pk_min_u16 v20, v20, v84
    v_pk_max_i16 v17, v17, v85
    v_pk_min_u16 v21, v21, v85
    v_pk_max_i16 v18, v18, v86
    v_pk_min_u16 v22, v22, v86
    v_pk_max_i16 v19, v19, v87
    v_pk_min_u16 v23, v23, v87
    s_waitcnt vmcnt(17)
    v_mfma_f32_16x16x32_bf16 v[12:15], v[8:11], v[88:91], v[12:15]
    v_pk_max_i16 v16, v16, v88
    v_pk_min_u16 v20, v20, v88
    v_pk_max_i16 v17, v17, v89
    v_pk_min_u16 v21, v21, v89
    v_pk_max_i16 v18, v18, v90
    v_pk_min_u16 v22, v22, v90
    v_pk_max_i16 v19, v19, v91
    v_pk_min_u16 v23, v23, v91
    s_waitcnt vmcnt(16)
    v_mfma_f32_16x16x32_bf16 v[12:15], v[8:11], v[92:95], v[12:15]
    v_pk_max_i16 v16, v16, v92
    v_pk_min_u16 v20, v20, v92
    v_pk_max_i16 v17, v17, v93
    v_pk_min_u16 v21, v21, v93
    v_pk_max_i16 v18, v18, v94
    v_pk_min_u16 v22, v22, v94
    v_pk_max_i16 v19, v19, v95
    v_pk_min_u16 v23, v23, v95
    s_waitcnt vmcnt(15)
    v_mfma_f32_16x16x32_bf16 v[12:15], v[8:11], v[96:99], v[12:15]
    v_pk_max_i16 v16, v16, v96
    v_pk_min_u16 v20, v20, v96
    v_pk_max_i16 v17, v17, v97
    v_pk_min_u16 v21, v21, v97
    v_pk_max_i16 v18, v18, v98
    v_pk_min_u16 v22, v22, v98
    v_pk_max_i16 v19, v19, v99
    v_pk_min_u16 v23, v23, v99
    s_waitcnt vmcnt(14)
    v_mfma_f32_16x16x32_bf16 v[12:15], v[8:11], v[100:103], v[12:15]
    v_pk_max_i16 v16, v16, v100
    v_pk_min_u16 v20, v20, v100
    v_pk_max_i16 v17, v17, v101
    v_pk_min_u16 v21, v21, v101
    v_pk_max_i16 v18, v18, v102
    v_pk_min_u16 v22, v22, v102
    v_pk_max_i16 v19, v19, v103
    v_pk_min_u16 v23, v23, v103
    s_waitcnt vmcnt(13)
    v_mfma_f32_16x16x32_bf16 v[12:15], v[8:11], v[104:107], v[12:15]
    v_pk_max_i16 v16, v16, v104
    v_pk_min_u16 v20, v20, v104
    v_pk_max_i16 v17, v17, v105
    v_pk_min_u16 v21, v21, v105
    v_pk_max_i16 v18, v18, v106
    v_pk_min_u16 v22, v22, v106
    v_pk_max_i16 v19, v19, v107
    v_pk_min_u16 v23, v23, v107
    s_waitcnt vmcnt(12)
    v_mfma_f32_16x16x32_bf16 v[12:15], v[8:11], v[108:111], v[12:15]
    v_pk_max_i16 v16, v16, v108
    v_pk_min_u16 v20, v20, v108
    v_pk_max_i16 v17, v17, v109
    v_pk_min_u16 v21, v21, v109
    v_pk_max_i16 v18, v18, v110
    v_pk_min_u16 v22, v22, v110
    v_pk_max_i16 v19, v19, v111
    v_pk_min_u16 v23, v23, v111
    s_waitcnt vmcnt(11)
    v_mfma_f32_16x16x32_bf16 v[12:15], v[8:11], v[112:115], v[12:15]
    v_pk_max_i16 v16, v16, v112
    v_pk_min_u16 v20, v20, v112
    v_pk_max_i16 v17, v17, v113
    v_pk_min_u16 v21, v21, v113
    v_pk_max_i16 v18, v18, v114
    v_pk_min_u16 v22, v22, v114
    v_pk_max_i16 v19, v19, v115
    v_pk_min_u16 v23, v23, v115
    s_waitcnt vmcnt(10)
    v_mfma_f32_16x16x32_bf16 v[12:15], v[8:11], v[116:119], v[12:15]
    v_pk_max_i16 v16, v16, v116
    v_pk_min_u16 v20, v20, v116
    v_pk_max_i16 v17, v17, v117
    v_pk_min_u16 v21, v21, v117
    v_pk_max_i16 v18, v18, v118
    v_pk_min_u16 v22, v22, v118
    v_pk_max_i16 v19, v19, v119
    v_pk_min_u16 v23, v23, v119
    s_waitcnt vmcnt(9)
    v_mfma_f32_16x16x32_bf16 v[12:15], v[8:11], v[120:123], v[12:15]
    v_pk_max_i16 v16, v16, v120
    v_pk_min_u16 v20, v20, v120
    v_pk_max_i16 v17, v17, v121
    v_pk_min_u16 v21, v21, v121
    v_pk_max_i16 v18, v18, v122
    v_pk_min_u16 v22, v22, v122
    v_pk_max_i16 v19, v19, v123
    v_pk_min_u16 v23, v23, v123
    s_waitcnt vmcnt(8)
    v_mfma_f32_16x16x32_bf16 v[12:15], v[8:11], v[124:127], v[12:15]
    v_pk_max_i16 v16, v16, v124
    v_pk_min_u16 v20, v20, v124
    v_pk_max_i16 v17, v17, v125
    v_pk_min_u16 v21, v21, v125
    v_pk_max_i16 v18, v18, v126
    v_pk_min_u16 v22, v22, v126
    v_pk_max_i16 v19, v19, v127
    v_pk_min_u16 v23, v23, v127
    s_waitcnt vmcnt(7)
    v_mfma_f32_16x16x32_bf16 v[12:15], v[8:11], v[128:131], v[12:15]
    v_pk_max_i16 v16, v16, v128
    v_pk_min_u16 v20, v20, v128
    v_pk_max_i16 v17, v17, v129
    v_pk_min_u16 v21, v21, v129
    v_pk_max_i16 v18, v18, v130
    v_pk_min_u16 v22, v22, v130
    v_pk_max_i16 v19, v19, v131
    v_pk_min_u16 v23, v23, v131
    s_waitcnt vmcnt(6)
    v_mfma_f32_16x16x32_bf16 v[12:15], v[8:11], v[132:135], v[12:15]
    v_pk_max_i16 v16, v16, v132
    v_pk_min_u16 v20, v20, v132
    v_pk_max_i16 v17, v17, v133
    v_pk_min_u16 v21, v21, v133
    v_pk_max_i16 v18, v18, v134
    v_pk_min_u16 v22, v22, v134
    v_pk_max_i16 v19, v19, v135
    v_pk_min_u16 v23, v23, v135
    s_waitcnt vmcnt(5)
    v_mfma_f32_16x16x32_bf16 v[12:15], v[8:11], v[136:139], v[12:15]
    v_pk_max_i16 v16, v16, v136
    v_pk_min_u16 v20, v20, v136
    v_pk_max_i16 v17, v17, v137
    v_pk_min_u16 v21, v21, v137
    v_pk_max_i16 v18, v18, v138
    v_pk_min_u16 v22, v22, v138
    v_pk_max_i16 v19, v19, v139
    v_pk_min_u16 v23, v23, v139
    s_waitcnt vmcnt(4)
    v_mfma_f32_16x16x32_bf16 v[12:15], v[8:11], v[140:143], v[12:15]
    v_pk_max_i16 v16, v16, v140
    v_pk_min_u16 v20, v20, v140
    v_pk_max_i16 v17, v17, v141
    v_pk_min_u16 v21, v21, v141
    v_pk_max_i16 v18, v18, v142
    v_pk_min_u16 v22, v22, v142
    v_pk_max_i16 v19, v19, v143
    v_pk_min_u16 v23, v23, v143
    s_waitcnt vmcnt(3)
    v_mfma_f32_16x16x32_bf16 v[12:15], v[8:11], v[144:147], v[12:15]
    v_pk_max_i16 v16, v16, v144
    v_pk_min_u16 v20, v20, v144
    v_pk_max_i16 v17, v17, v145
    v_pk_min_u16 v21, v21, v145
    v_pk_max_i16 v18, v18, v146
    v_pk_min_u16 v22, v22, v146
    v_pk_max_i16 v19, v19, v147
    v_pk_min_u16 v23, v23, v147
    s_waitcnt vmcnt(2)
    v_mfma_f32_16x16x32_bf16 v[12:15], v[8:11], v[148:151], v[12:15]
    v_pk_max_i16 v16, v16, v148
    v_pk_min_u16 v20, v20, v148
    v_pk_max_i16 v17, v17, v149
    v_pk_min_u16 v21, v21, v149
    v_pk_max_i16 v18, v18, v150
    v_pk_min_u16 v22, v22, v150
    v_pk_max_i16 v19, v19, v151
    v_pk_min_u16 v23, v23, v151
    s_waitcnt vmcnt(1)
    v_mfma_f32_16x16x32_bf16 v[12:15], v[8:11], v[152:155], v[12:15]
    v_pk_max_i16 v16, v16, v152
    v_pk_min_u16 v20, v20, v152
    v_pk_max_i16 v17, v17, v153
    v_pk_min_u16 v21, v21, v153
    v_pk_max_i16 v18, v18, v154
    v_pk_min_u16 v22, v22, v154
    v_pk_max_i16 v19, v19, v155
    v_pk_min_u16 v23, v23, v155
    s_waitcnt vmcnt(0)
    v_mfma_f32_16x16x32_bf16 v[12:15], v[8:11], v[156:159], v[12:15]
    v_pk_max_i16 v16, v16, v156
    v_pk_min_u16 v20, v20, v156
    v_pk_max_i16 v17, v17, v157
    v_pk_min_u16 v21, v21, v157
    v_pk_max_i16 v18, v18, v158
    v_pk_min_u16 v22, v22, v158
    v_pk_max_i16 v19, v19, v159
    v_pk_min_u16 v23, v23, v159
    v_pk_ashrrev_i16 v24, 15, v16 op_sel_hi:[0,1]
    v_xor_b32 v20, s33, v20
    v_pk_ashrrev_i16 v25, 15, v17 op_sel_hi:[0,1]
    v_xor_b32 v21, s33, v21
    v_pk_ashrrev_i16 v26, 15, v18 op_sel_hi:[0,1]
    v_xor_b32 v22, s33, v22
    v_pk_ashrrev_i16 v27, 15, v19 op_sel_hi:[0,1]
    v_xor_b32 v23, s33, v23
    v_bfi_b32 v16, v24, v20, v16
    v_bfi_b32 v18, v26, v22, v18
    v_bfi_b32 v17, v25, v21, v17
    v_bfi_b32 v19, v27, v23, v19
    v_permlane32_swap_b32 v16, v18
    v_add_f32_dpp v12, v12, v12 row_ror:8 row_mask:0xf bank_mask:0xf
    v_permlane32_swap_b32 v17, v19
    v_pk_max_i16 v16, v16, v18
    v_pk_max_i16 v17, v17, v19
    v_add_f32_dpp v13, v13, v13 row_ror:8 row_mask:0xf bank_mask:0xf
    v_mov_b32 v15, s34
    v_permlane16_swap_b32 v16, v17
    v_pk_max_i16 v16, v16, v17
    s_nop 1
    v_mov_b32_dpp v17, v16 row_ror:8 row_mask:0xf bank_mask:0xf
    v_pk_max_i16 v14, v16, v17
    s_mov_b32 exec_lo, 0x00ff00ff
    s_mov_b32 exec_hi, 0x00ff00ff
    buffer_store_dwordx4 v[12:15], v40, s[40:43], s35 offen
    s_mov_b64 exec, -1
    s_barrier
    s_mov_b32 s36, s6
    s_mov_b32 s37, s7
    s_add_u32 m0, s32, 0
    s_add_u32 s30, s32, 0
    buffer_load_dwordx4 v4, s[36:39], s30 offen offset:0 lds
    buffer_load_dwordx4 v4, s[36:39], s30 offen offset:1024 lds
    buffer_load_dwordx4 v4, s[36:39], s30 offen offset:2048 lds
    buffer_load_dwordx4 v4, s[36:39], s30 offen offset:3072 lds
    s_add_u32 m0, s32, 4096
    s_add_u32 s30, s32, 4096
    buffer_load_dwordx4 v4, s[36:39], s30 offen offset:0 lds
    buffer_load_dwordx4 v4, s[36:39], s30 offen offset:1024 lds
    s_mov_b32 s36, s8
    s_mov_b32 s37, s9
    s_add_u32 m0, s32, 18432
    s_add_u32 s30, s32, 0
    buffer_load_dwordx4 v4, s[36:39], s30 offen offset:0 lds
    buffer_load_dwordx4 v4, s[36:39], s30 offen offset:1024 lds
    buffer_load_dwordx4 v4, s[36:39], s30 offen offset:2048 lds
    buffer_load_dwordx4 v4, s[36:39], s30 offen offset:3072 lds
    s_add_u32 m0, s32, 22528
    s_add_u32 s30, s32, 4096
    buffer_load_dwordx4 v4, s[36:39], s30 offen offset:0 lds
    buffer_load_dwordx4 v4, s[36:39], s30 offen offset:1024 lds
L_nodma:
    s_add_u32 s35, s35, 1048576
    s_add_u32 s17, s16, 1
    s_cmp_eq_u32 s17, 3
    s_cselect_b32 s17, 0, s17
    s_add_u32 s18, s16, s17
    s_sub_u32 s18, 3, s18
    v_bfe_u32 v5, v0, 2, 2
    v_lshrrev_b32 v6, 4, v0
    v_and_b32 v7, 3, v0
    v_lshl_add_u32 v24, v6, 3, v5
    v_mul_u32_u24 v24, 96, v24
    v_lshl_add_u32 v24, v7, 3, v24
    s_mul_i32 s30, s17, 6144
    s_mul_i32 s31, s18, 6144
    v_add_u32 v30, s30, v24
    v_add_u32 v31, s31, v24
    v_add_u32 v29, s32, v24
    v_lshrrev_b32 v25, 2, v0
    v_mul_u32_u24 v25, 384, v25
    v_lshl_add_u32 v25, v7, 3, v25
    v_add_u32 v25, s19, v25
    v_bfe_u32 v5, v0, 3, 2
    v_lshrrev_b32 v2, 5, v0
    v_lshlrev_b32 v8, 7, v2
    v_lshl_add_u32 v8, v5, 10, v8
    v_lshl_add_u32 v8, v3, 4, v8
    v_lshl_add_u32 v5, v3, 2, v5
    v_lshl_add_u32 v5, v5, 1, v2
    v_lshl_add_u32 v5, v5, 1, s19
    v_and_b32 v7, 1, v0
    v_mul_u32_u24 v7, 384, v7
    v_lshl_add_u32 v7, v6, 4, v7
    s_lshl_b32 s30, s17, 7
    s_lshl_b32 s31, s18, 7
    v_add_u32 v2, s30, v7
    v_add_u32 v6, s31, v7
    v_add_u32 v7, s19, v7
    s_lshl_b32 s30, s16, 8
    v_lshl_add_u32 v4, v0, 2, s30
    v_lshl_add_u32 v3, v3, 5, s30
    s_mul_i32 s30, s12, 12288
    s_lshl_b32 s31, s16, 12
    s_add_u32 s30, s30, s31
    s_add_u32 s30, s30, 524288
    s_mov_b32 s50, 0xffff0000
    s_mov_b32 s51, 0xffff0000
    s_mov_b32 s52, 0
    s_mov_b32 s53, -1
    s_brev_b32 s33, -2
    s_waitcnt vmcnt(0)
    s_barrier
    ds_read_b64_tr_b16 v[160:161], v29 offset:0
    ds_read_b64_tr_b16 v[162:163], v29 offset:384
    ds_read_b64_tr_b16 v[164:165], v29 offset:3072
    ds_read_b64_tr_b16 v[166:167], v29 offset:3456
    ds_read_b64_tr_b16 v[168:169], v30 offset:0
    ds_read_b64_tr_b16 v[170:171], v30 offset:384
    ds_read_b64_tr_b16 v[172:173], v30 offset:3072
    ds_read_b64_tr_b16 v[174:175], v30 offset:3456
    ds_read_b64_tr_b16 v[176:177], v31 offset:0
    ds_read_b64_tr_b16 v[178:179], v31 offset:384
    ds_read_b64_tr_b16 v[180:181], v31 offset:3072
    ds_read_b64_tr_b16 v[182:183], v31 offset:3456
    ds_read_b64_tr_b16 v[184:185], v29 offset:32
    ds_read_b64_tr_b16 v[186:187], v29 offset:416
    ds_read_b64_tr_b16 v[188:189], v29 offset:3104
    ds_read_b64_tr_b16 v[190:191], v29 offset:3488
    ds_read_b64_tr_b16 v[192:193], v30 offset:32
    ds_read_b64_tr_b16 v[194:195], v30 offset:416
    ds_read_b64_tr_b16 v[196:197], v30 offset:3104
    ds_read_b64_tr_b16 v[198:199], v30 offset:3488
    ds_read_b64_tr_b16 v[200:201], v31 offset:32
    s_branch L_p2
L_slow2:
    s_cmp_gt_u32 s31, 524288
    s_cbranch_scc1 L_to2
    s_cmp_lg_u32 s31, 12
    s_cbranch_scc1 L_poll2r
    s_mov_b32 exec_lo, 0x00ff00ff
    s_mov_b32 exec_hi, 0x00ff00ff
    buffer_store_dwordx4 v[12:15], v40, s[40:43], s35 offen sc1
    s_mov_b64 exec, -1
    s_waitcnt vmcnt(0)
    s_branch L_poll2r
L_to2:
    s_waitcnt vmcnt(0)
    s_branch L_poll2x
L_slow1:
    s_cmp_gt_u32 s31, 524288
    s_cbranch_scc1 L_to1
    s_xor_b32 s30, s30, 1048576
    s_branch L_poll1r
L_to1:
    s_waitcnt vmcnt(0)
    s_branch L_poll1x
L_helper:
    s_mul_i32 s13, s13, 3
    s_add_u32 s13, s13, s16
    v_lshlrev_b32 v5, 7, v0
    s_cmp_lt_u32 s13, 6
    s_cselect_b32 s33, 0, 6
    s_sub_u32 s33, s13, s33
    s_mul_i32 s33, s33, 3072
    s_mul_i32 s30, s12, 12
    s_add_u32 s30, s30, s13
    s_lshl_b32 s31, s30, 10
    s_lshl_b32 s30, s30, 12
    s_add_u32 s30, s30, 4096
    s_add_u32 s31, s31, 524288
    s_waitcnt lgkmcnt(0)
    s_load_dword s34, s[40:41], 0
    s_cmp_lt_u32 s13, 6
    s_cselect_b32 s36, s6, s8
    s_cselect_b32 s37, s7, s9
    s_mov_b64 exec, 0xffffff
    buffer_load_dword v43, v5, s[36:39], s33 offen
    s_mov_b64 exec, -1
    buffer_load_dword v47, v4, s[40:43], s31 offen sc1
    v_lshrrev_b32 v5, 3, v0
    v_mul_u32_u24 v5, 12288, v5
    v_lshl_add_u32 v5, v3, 4, v5
    s_lshl_b32 s35, s13, 10
    s_lshl_b32 s31, s12, 7
    s_add_u32 s35, s35, s31
    s_add_u32 s35, s35, 524288
    v_mov_b32 v36, 0
    v_mov_b32 v37, 0
    v_mov_b32 v38, 0x80008000
    s_waitcnt lgkmcnt(0)
    s_mul_i32 s34, s34, 1664525
    s_add_u32 s34, s34, 1013904223
    v_mov_b32 v39, s34
    s_mov_b32 s31, 0
    s_waitcnt vmcnt(0)
    v_mov_b32 v27, s34
    v_mov_b32 v76, v36
    v_mov_b32 v77, v37
    v_mov_b32 v78, v38
    v_mov_b32 v79, v39
    v_mov_b32 v92, v36
    v_mov_b32 v93, v37
    v_mov_b32 v94, v38
    v_mov_b32 v95, v39
    buffer_load_dwordx4 v[64:67], v4, s[40:43], s30 offen offset:0 sc1
    buffer_load_dwordx4 v[68:71], v4, s[40:43], s30 offen offset:1024 sc1
    buffer_load_dwordx4 v[72:75], v4, s[40:43], s30 offen offset:2048 sc1
    s_mov_b64 exec, 0xffffffff
    buffer_load_dwordx4 v[76:79], v4, s[40:43], s30 offen offset:3072 sc1
    s_mov_b64 exec, -1
L_poll1:
    s_add_u32 s31, s31, 1
    s_cmp_ge_u32 s31, 40
    s_cbranch_scc1 L_slow1
L_poll1r:
    buffer_load_dwordx4 v[80:83], v4, s[40:43], s30 offen offset:0 sc1
    buffer_load_dwordx4 v[84:87], v4, s[40:43], s30 offen offset:1024 sc1
    buffer_load_dwordx4 v[88:91], v4, s[40:43], s30 offen offset:2048 sc1
    s_mov_b64 exec, 0xffffffff
    buffer_load_dwordx4 v[92:95], v4, s[40:43], s30 offen offset:3072 sc1
    s_mov_b64 exec, -1
    s_waitcnt vmcnt(6)
    v_cmp_ne_u32 vcc, s34, v67
    v_cmp_ne_u32 s[44:45], s34, v71
    v_pk_max_i16 v26, v66, v70
    v_pk_add_f32 v[24:25], v[64:65], v[68:69]
    s_or_b64 s[44:45], vcc, s[44:45]
    s_waitcnt vmcnt(4)
    v_cmp_ne_u32 vcc, s34, v75
    v_cmp_ne_u32 s[46:47], s34, v79
    v_pk_max_i16 v34, v74, v78
    v_pk_add_f32 v[32:33], v[72:73], v[76:77]
    v_pk_max_i16 v26, v26, v34
    v_pk_add_f32 v[24:25], v[24:25], v[32:33]
    s_or_b64 s[44:45], vcc, s[44:45]
    s_or_b64 s[44:45], s[44:45], s[46:47]
    s_cbranch_scc0 L_poll1x
    buffer_load_dwordx4 v[64:67], v4, s[40:43], s30 offen offset:0 sc1
    buffer_load_dwordx4 v[68:71], v4, s[40:43], s30 offen offset:1024 sc1
    buffer_load_dwordx4 v[72:75], v4, s[40:43], s30 offen offset:2048 sc1
    s_mov_b64 exec, 0xffffffff
    buffer_load_dwordx4 v[76:79], v4, s[40:43], s30 offen offset:3072 sc1
    s_mov_b64 exec, -1
    s_waitcnt vmcnt(6)
    v_cmp_ne_u32 vcc, s34, v83
    v_cmp_ne_u32 s[44:45], s34, v87
    v_pk_max_i16 v26, v82, v86
    v_pk_add_f32 v[24:25], v[80:81], v[84:85]
    s_or_b64 s[44:45], vcc, s[44:45]
    s_waitcnt vmcnt(4)
    v_cmp_ne_u32 vcc, s34, v91
    v_cmp_ne_u32 s[46:47], s34, v95
    v_pk_max_i16 v34, v90, v94
    v_pk_add_f32 v[32:33], v[88:89], v[92:93]
    v_pk_max_i16 v26, v26, v34
    v_pk_add_f32 v[24:25], v[24:25], v[32:33]
    s_or_b64 s[44:45], vcc, s[44:45]
    s_or_b64 s[44:45], s[44:45], s[46:47]
    s_cbranch_scc1 L_poll1
L_poll1x:
    s_nop 0
    v_mov_b32_dpp v30, v26 row_ror:8 row_mask:0xf bank_mask:0xf
    v_add_f32_dpp v24, v24, v24 row_ror:8 row_mask:0xf bank_mask:0xf
    v_add_f32_dpp v25, v25, v25 row_ror:8 row_mask:0xf bank_mask:0xf
    v_pk_max_i16 v26, v26, v30
    v_mov_b32 v28, v24
    v_mov_b32 v29, v25
    v_mov_b32 v30, v26
    v_permlane16_swap_b32 v24, v28
    v_permlane16_swap_b32 v25, v29
    v_permlane16_swap_b32 v26, v30
    v_add_f32 v24, v24, v28
    v_add_f32 v25, v25, v29
    v_pk_max_i16 v26, v26, v30
    v_mov_b32 v28, v24
    v_mov_b32 v29, v25
    v_mov_b32 v30, v26
    v_permlane32_swap_b32 v24, v28
    v_permlane32_swap_b32 v25, v29
    v_permlane32_swap_b32 v26, v30
    v_add_f32 v24, v24, v28
    v_add_f32 v25, v25, v29
    v_pk_max_i16 v26, v26, v30
    buffer_store_dwordx4 v[24:27], v5, s[40:43], s35 offen sc1
    s_waitcnt vmcnt(0)
    s_cmp_lg_u32 s13, 0
    s_cbranch_scc1 L_end
    s_mul_i32 s30, s12, 12288
    s_add_u32 s30, s30, 524288
    s_add_u32 s33, s30, 4096
    v_lshlrev_b32 v5, 7, v0
    s_mov_b32 s31, 0
    s_waitcnt vmcnt(0)
L_poll3:
    buffer_load_dword v24, v5, s[40:43], s30 offen offset:12 sc1
    buffer_load_dword v25, v5, s[40:43], s33 offen offset:12 sc1
    s_add_u32 s31, s31, 1
    s_cmp_gt_u32 s31, 524288
    s_cbranch_scc1 L_poll3x
    s_waitcnt vmcnt(0)
    v_cmp_ne_u32 vcc, s34, v24
    v_cmp_ne_u32 s[44:45], s34, v25
    s_or_b64 vcc, vcc, s[44:45]
    s_cbranch_scc1 L_poll3
L_poll3x:
    v_mov_b32 v27, s34
    buffer_wbl2 sc1
    s_cmp_lg_u32 s2, 0
    s_cbranch_scc1 L_noep
    s_mov_b64 exec, 1
    buffer_store_dword v27, v4, s[40:43], 0 offen sc1
    s_mov_b64 exec, -1
L_noep:
    s_endpgm
    .p2alignl 12, 0xbf810000
L_p2:
    ds_read_b64_tr_b16 v[202:203], v31 offset:416
    ds_read_b64_tr_b16 v[204:205], v31 offset:3104
    ds_read_b64_tr_b16 v[206:207], v31 offset:3488
    ds_read_b64_tr_b16 v[208:209], v29 offset:64
    ds_read_b64_tr_b16 v[210:211], v29 offset:448
    ds_read_b64_tr_b16 v[212:213], v29 offset:3136
    ds_read_b64_tr_b16 v[214:215], v29 offset:3520
    ds_read_b64_tr_b16 v[216:217], v30 offset:64
    ds_read_b64_tr_b16 v[218:219], v30 offset:448
    ds_read_b64_tr_b16 v[220:221], v30 offset:3136
    ds_read_b64_tr_b16 v[222:223], v30 offset:3520
    ds_read_b64_tr_b16 v[224:225], v31 offset:64
    ds_read_b64_tr_b16 v[226:227], v31 offset:448
    ds_read_b64_tr_b16 v[228:229], v31 offset:3136
    ds_read_b64_tr_b16 v[230:231], v31 offset:3520
    ds_read_b64_tr_b16 v[232:233], v25 offset:18432
    ds_read_b64_tr_b16 v[234:235], v25 offset:24576
    ds_read_b64_tr_b16 v[248:249], v25 offset:30720
    ds_read_b64_tr_b16 v[236:237], v25 offset:18464
    ds_read_b64_tr_b16 v[238:239], v25 offset:24608
    ds_read_b64_tr_b16 v[250:251], v25 offset:30752
    ds_read_b64_tr_b16 v[240:241], v25 offset:18496
    ds_read_b64_tr_b16 v[242:243], v25 offset:24640
    ds_read_b64_tr_b16 v[252:253], v25 offset:30784
    ds_read_b64_tr_b16 v[244:245], v25 offset:18528
    ds_read_b64_tr_b16 v[246:247], v25 offset:24672
    ds_read_b64_tr_b16 v[254:255], v25 offset:30816
    s_mov_b32 s31, 0
    s_waitcnt lgkmcnt(0)
L_poll2:
    buffer_load_dwordx4 v[24:27], v8, s[40:43], s30 offen offset:0 sc1
    buffer_load_dwordx4 v[28:31], v8, s[40:43], s30 offen offset:256 sc1
    buffer_load_dwordx4 v[32:35], v8, s[40:43], s30 offen offset:512 sc1
    buffer_load_dwordx4 v[36:39], v8, s[40:43], s30 offen offset:768 sc1
    s_add_u32 s31, s31, 1
    s_cmp_ge_u32 s31, 12
    s_cbranch_scc1 L_slow2
L_poll2r:
    s_waitcnt vmcnt(2)
    v_cmp_ne_u32 vcc, s34, v27
    v_cmp_ne_u32 s[44:45], s34, v31
    v_pk_max_i16 v26, v26, v30
    v_pk_add_f32 v[24:25], v[24:25], v[28:29]
    s_or_b64 s[44:45], vcc, s[44:45]
    s_waitcnt vmcnt(0)
    v_cmp_ne_u32 vcc, s34, v35
    v_cmp_ne_u32 s[46:47], s34, v39
    v_pk_max_i16 v34, v34, v38
    v_pk_add_f32 v[32:33], v[32:33], v[36:37]
    v_pk_max_i16 v26, v26, v34
    v_pk_add_f32 v[24:25], v[24:25], v[32:33]
    s_or_b64 s[44:45], vcc, s[44:45]
    s_or_b64 s[44:45], s[44:45], s[46:47]
    s_cbranch_scc1 L_poll2
L_poll2x:
    v_lshlrev_b32 v27, 16, v26
    s_nop 0
    v_permlane32_swap_b32 v24, v25
    v_permlane32_swap_b32 v27, v26
    v_add_f32 v24, v24, v25
    v_max_i32 v26, v26, v27
    v_mul_f32 v24, 0x37a72f05, v24
    v_ashrrev_i32 v27, 31, v26
    v_cvt_pk_bf16_f32 v24, v24, v24
    v_bitop3_b32 v26, v26, v27, s33 bitop3:0x78
    ds_write_b16 v5, v24 offset:36864
    ds_write_b16_d16_hi v5, v26 offset:37248
    ds_read_b128 v[24:27], v7 offset:36864
    ds_read_b128 v[28:31], v7 offset:36928
    s_waitcnt lgkmcnt(2)
    s_barrier
    ds_read_b128 v[32:35], v2 offset:36864
    ds_read_b128 v[36:39], v2 offset:36928
    ds_read_b128 v[40:43], v6 offset:36864
    ds_read_b128 v[44:47], v6 offset:36928
    s_waitcnt lgkmcnt(5)
    v_mfma_f32_16x16x32_bf16 v[8:11], v[160:163], v[24:27], 0
    v_mfma_f32_16x16x32_bf16 v[12:15], v[184:187], v[24:27], 0
    v_mfma_f32_16x16x32_bf16 v[16:19], v[208:211], v[24:27], 0
    s_waitcnt lgkmcnt(4)
    v_mfma_f32_16x16x32_bf16 v[8:11], v[164:167], v[28:31], v[8:11]
    v_mfma_f32_16x16x32_bf16 v[12:15], v[188:191], v[28:31], v[12:15]
    v_mfma_f32_16x16x32_bf16 v[16:19], v[212:215], v[28:31], v[16:19]
    s_waitcnt lgkmcnt(3)
    v_mfma_f32_16x16x32_bf16 v[8:11], v[168:171], v[32:35], v[8:11]
    s_waitcnt lgkmcnt(2)
    v_mfma_f32_16x16x32_bf16 v[8:11], v[172:175], v[36:39], v[8:11]
    s_waitcnt lgkmcnt(1)
    v_mfma_f32_16x16x32_bf16 v[8:11], v[176:179], v[40:43], v[8:11]
    s_waitcnt lgkmcnt(0)
    v_mfma_f32_16x16x32_bf16 v[8:11], v[180:183], v[44:47], v[8:11]
    v_mfma_f32_16x16x32_bf16 v[12:15], v[192:195], v[32:35], v[12:15]
    s_nop 1
    v_mfma_f32_16x16x32_bf16 v[12:15], v[196:199], v[36:39], v[12:15]
    s_nop 1
    v_mfma_f32_16x16x32_bf16 v[12:15], v[200:203], v[40:43], v[12:15]
    s_nop 0
    v_maximum3_f32 v8, v8, 0, 0
    v_mfma_f32_16x16x32_bf16 v[12:15], v[204:207], v[44:47], v[12:15]
    v_maximum3_f32 v9, v9, 0, 0
    v_maximum3_f32 v10, v10, 0, 0
    v_mfma_f32_16x16x32_bf16 v[16:19], v[216:219], v[32:35], v[16:19]
    v_maximum3_f32 v11, v11, 0, 0
    v_cvt_pk_bf16_f32 v20, v8, v9
    v_mfma_f32_16x16x32_bf16 v[16:19], v[220:223], v[36:39], v[16:19]
    v_cvt_pk_bf16_f32 v21, v10, v11
    s_nop 0
    v_mfma_f32_16x16x32_bf16 v[16:19], v[224:227], v[40:43], v[16:19]
    v_maximum3_f32 v12, v12, 0, 0
    v_maximum3_f32 v13, v13, 0, 0
    v_mfma_f32_16x16x32_bf16 v[16:19], v[228:231], v[44:47], v[16:19]
    v_maximum3_f32 v14, v14, 0, 0
    v_maximum3_f32 v15, v15, 0, 0
    v_cvt_pk_bf16_f32 v22, v12, v13
    v_cvt_pk_bf16_f32 v23, v14, v15
    s_nop 1
    v_mfma_f32_16x16x32_bf16 v[24:27], v[20:23], v[232:235], 0
    s_nop 0
    v_maximum3_f32 v16, v16, 0, 0
    v_mfma_f32_16x16x32_bf16 v[28:31], v[20:23], v[236:239], 0
    v_maximum3_f32 v17, v17, 0, 0
    v_maximum3_f32 v18, v18, 0, 0
    v_mfma_f32_16x16x32_bf16 v[32:35], v[20:23], v[240:243], 0
    v_maximum3_f32 v19, v19, 0, 0
    v_cvt_pk_bf16_f32 v8, v16, v17
    v_mfma_f32_16x16x32_bf16 v[36:39], v[20:23], v[244:247], 0
    v_cvt_pk_bf16_f32 v9, v18, v19
    s_nop 1
    v_mfma_f32_16x16x16_bf16 v[24:27], v[8:9], v[248:249], v[24:27]
    v_mfma_f32_16x16x16_bf16 v[28:31], v[8:9], v[250:251], v[28:31]
    v_mfma_f32_16x16x16_bf16 v[32:35], v[8:9], v[252:253], v[32:35]
    v_mfma_f32_16x16x16_bf16 v[36:39], v[8:9], v[254:255], v[36:39]
    s_nop 5
    v_cndmask_b32 v24, v24, v28, s[50:51]
    v_cndmask_b32 v25, v25, v29, s[50:51]
    v_cndmask_b32 v32, v32, v36, s[50:51]
    v_cndmask_b32 v33, v33, v37, s[50:51]
    v_cndmask_b32 v24, v24, v32, s[52:53]
    v_cndmask_b32 v25, v25, v33, s[52:53]
    v_cvt_pk_bf16_f32 v24, 0, v24
    v_cvt_pk_bf16_f32 v25, 0, v25
    v_add_f32 v24, v24, v25
    v_cvt_pk_bf16_f32 v24, 0, v24
    v_mul_f32 v24, 0xbfb8aa3b, v24
    v_exp_f32 v24, v24
    s_nop 0
    v_add_f32 v24, 1.0, v24
    v_rcp_f32 v24, v24
    s_nop 0
    v_cvt_pk_bf16_f32 v24, 0, v24
    ds_write_b32 v4, v24 offset:37632
    ds_read_b128 v[8:11], v3 offset:37632
    ds_read_b128 v[12:15], v3 offset:37648
    v_lshlrev_b32 v16, 16, v48
    v_and_b32 v17, s50, v48
    v_lshlrev_b32 v18, 16, v49
    v_and_b32 v19, s50, v49
    v_lshlrev_b32 v20, 16, v50
    v_and_b32 v21, s50, v50
    v_lshlrev_b32 v22, 16, v51
    v_and_b32 v23, s50, v51
    v_lshlrev_b32 v40, 16, v52
    v_and_b32 v41, s50, v52
    v_lshlrev_b32 v42, 16, v53
    v_and_b32 v43, s50, v53
    v_lshlrev_b32 v44, 16, v54
    v_and_b32 v45, s50, v54
    v_lshlrev_b32 v46, 16, v55
    v_and_b32 v47, s50, v55
    s_waitcnt lgkmcnt(0)
    v_pk_mul_f32 v[16:17], v[16:17], v[8:9]
    v_pk_mul_f32 v[18:19], v[18:19], v[10:11]
    v_pk_mul_f32 v[20:21], v[20:21], v[12:13]
    v_pk_mul_f32 v[22:23], v[22:23], v[14:15]
    v_cvt_pk_bf16_f32 v48, v16, v17
    v_cvt_pk_bf16_f32 v49, v18, v19
    v_cvt_pk_bf16_f32 v50, v20, v21
    v_cvt_pk_bf16_f32 v51, v22, v23
    buffer_store_dwordx4 v[48:51], v1, s[24:27], 0 offen offset:0 sc1
    v_pk_mul_f32 v[40:41], v[40:41], v[8:9]
    v_pk_mul_f32 v[42:43], v[42:43], v[10:11]
    v_pk_mul_f32 v[44:45], v[44:45], v[12:13]
    v_pk_mul_f32 v[46:47], v[46:47], v[14:15]
    v_cvt_pk_bf16_f32 v52, v40, v41
    v_cvt_pk_bf16_f32 v53, v42, v43
    v_cvt_pk_bf16_f32 v54, v44, v45
    v_cvt_pk_bf16_f32 v55, v46, v47
    buffer_store_dwordx4 v[52:55], v1, s[24:27], 0 offen offset:3072 sc1
    v_lshlrev_b32 v16, 16, v56
    v_and_b32 v17, s50, v56
    v_lshlrev_b32 v18, 16, v57
    v_and_b32 v19, s50, v57
    v_lshlrev_b32 v20, 16, v58
    v_and_b32 v21, s50, v58
    v_lshlrev_b32 v22, 16, v59
    v_and_b32 v23, s50, v59
    v_pk_mul_f32 v[16:17], v[16:17], v[8:9]
    v_pk_mul_f32 v[18:19], v[18:19], v[10:11]
    v_pk_mul_f32 v[20:21], v[20:21], v[12:13]
    v_pk_mul_f32 v[22:23], v[22:23], v[14:15]
    s_mov_b32 s30, 6144
    v_cvt_pk_bf16_f32 v56, v16, v17
    v_cvt_pk_bf16_f32 v57, v18, v19
    v_cvt_pk_bf16_f32 v58, v20, v21
    v_cvt_pk_bf16_f32 v59, v22, v23
    buffer_store_dwordx4 v[56:59], v1, s[24:27], s30 offen offset:0 sc1
    v_lshlrev_b32 v40, 16, v60
    v_and_b32 v41, s50, v60
    v_lshlrev_b32 v42, 16, v61
    v_and_b32 v43, s50, v61
    v_lshlrev_b32 v44, 16, v62
    v_and_b32 v45, s50, v62
    v_lshlrev_b32 v46, 16, v63
    v_and_b32 v47, s50, v63
    v_pk_mul_f32 v[40:41], v[40:41], v[8:9]
    v_pk_mul_f32 v[42:43], v[42:43], v[10:11]
    v_pk_mul_f32 v[44:45], v[44:45], v[12:13]
    v_pk_mul_f32 v[46:47], v[46:47], v[14:15]
    v_cvt_pk_bf16_f32 v60, v40, v41
    v_cvt_pk_bf16_f32 v61, v42, v43
    v_cvt_pk_bf16_f32 v62, v44, v45
    v_cvt_pk_bf16_f32 v63, v46, v47
    buffer_store_dwordx4 v[60:63], v1, s[24:27], s30 offen offset:3072 sc1
    v_lshlrev_b32 v16, 16, v64
    v_and_b32 v17, s50, v64
    v_lshlrev_b32 v18, 16, v65
    v_and_b32 v19, s50, v65
    v_lshlrev_b32 v20, 16, v66
    v_and_b32 v21, s50, v66
    v_lshlrev_b32 v22, 16, v67
    v_and_b32 v23, s50, v67
    v_pk_mul_f32 v[16:17], v[16:17], v[8:9]
    v_pk_mul_f32 v[18:19], v[18:19], v[10:11]
    v_pk_mul_f32 v[20:21], v[20:21], v[12:13]
    v_pk_mul_f32 v[22:23], v[22:23], v[14:15]
    s_mov_b32 s30, 12288
    v_cvt_pk_bf16_f32 v64, v16, v17
    v_cvt_pk_bf16_f32 v65, v18, v19
    v_cvt_pk_bf16_f32 v66, v20, v21
    v_cvt_pk_bf16_f32 v67, v22, v23
    buffer_store_dwordx4 v[64:67], v1, s[24:27], s30 offen offset:0 sc1
    v_lshlrev_b32 v40, 16, v68
    v_and_b32 v41, s50, v68
    v_lshlrev_b32 v42, 16, v69
    v_and_b32 v43, s50, v69
    v_lshlrev_b32 v44, 16, v70
    v_and_b32 v45, s50, v70
    v_lshlrev_b32 v46, 16, v71
    v_and_b32 v47, s50, v71
    v_pk_mul_f32 v[40:41], v[40:41], v[8:9]
    v_pk_mul_f32 v[42:43], v[42:43], v[10:11]
    v_pk_mul_f32 v[44:45], v[44:45], v[12:13]
    v_pk_mul_f32 v[46:47], v[46:47], v[14:15]
    v_cvt_pk_bf16_f32 v68, v40, v41
    v_cvt_pk_bf16_f32 v69, v42, v43
    v_cvt_pk_bf16_f32 v70, v44, v45
    v_cvt_pk_bf16_f32 v71, v46, v47
    buffer_store_dwordx4 v[68:71], v1, s[24:27], s30 offen offset:3072 sc1
    v_lshlrev_b32 v16, 16, v72
    v_and_b32 v17, s50, v72
    v_lshlrev_b32 v18, 16, v73
    v_and_b32 v19, s50, v73
    v_lshlrev_b32 v20, 16, v74
    v_and_b32 v21, s50, v74
    v_lshlrev_b32 v22, 16, v75
    v_and_b32 v23, s50, v75
    v_pk_mul_f32 v[16:17], v[16:17], v[8:9]
    v_pk_mul_f32 v[18:19], v[18:19], v[10:11]
    v_pk_mul_f32 v[20:21], v[20:21], v[12:13]
    v_pk_mul_f32 v[22:23], v[22:23], v[14:15]
    s_mov_b32 s30, 18432
    v_cvt_pk_bf16_f32 v72, v16, v17
    v_cvt_pk_bf16_f32 v73, v18, v19
    v_cvt_pk_bf16_f32 v74, v20, v21
    v_cvt_pk_bf16_f32 v75, v22, v23
    buffer_store_dwordx4 v[72:75], v1, s[24:27], s30 offen offset:0 sc1
    v_lshlrev_b32 v40, 16, v76
    v_and_b32 v41, s50, v76
    v_lshlrev_b32 v42, 16, v77
    v_and_b32 v43, s50, v77
    v_lshlrev_b32 v44, 16, v78
    v_and_b32 v45, s50, v78
    v_lshlrev_b32 v46, 16, v79
    v_and_b32 v47, s50, v79
    v_pk_mul_f32 v[40:41], v[40:41], v[8:9]
    v_pk_mul_f32 v[42:43], v[42:43], v[10:11]
    v_pk_mul_f32 v[44:45], v[44:45], v[12:13]
    v_pk_mul_f32 v[46:47], v[46:47], v[14:15]
    v_cvt_pk_bf16_f32 v76, v40, v41
    v_cvt_pk_bf16_f32 v77, v42, v43
    v_cvt_pk_bf16_f32 v78, v44, v45
    v_cvt_pk_bf16_f32 v79, v46, v47
    buffer_store_dwordx4 v[76:79], v1, s[24:27], s30 offen offset:3072 sc1
    v_lshlrev_b32 v16, 16, v80
    v_and_b32 v17, s50, v80
    v_lshlrev_b32 v18, 16, v81
    v_and_b32 v19, s50, v81
    v_lshlrev_b32 v20, 16, v82
    v_and_b32 v21, s50, v82
    v_lshlrev_b32 v22, 16, v83
    v_and_b32 v23, s50, v83
    v_pk_mul_f32 v[16:17], v[16:17], v[8:9]
    v_pk_mul_f32 v[18:19], v[18:19], v[10:11]
    v_pk_mul_f32 v[20:21], v[20:21], v[12:13]
    v_pk_mul_f32 v[22:23], v[22:23], v[14:15]
    s_mov_b32 s30, 24576
    v_cvt_pk_bf16_f32 v80, v16, v17
    v_cvt_pk_bf16_f32 v81, v18, v19
    v_cvt_pk_bf16_f32 v82, v20, v21
    v_cvt_pk_bf16_f32 v83, v22, v23
    buffer_store_dwordx4 v[80:83], v1, s[24:27], s30 offen offset:0 sc1
    v_lshlrev_b32 v40, 16, v84
    v_and_b32 v41, s50, v84
    v_lshlrev_b32 v42, 16, v85
    v_and_b32 v43, s50, v85
    v_lshlrev_b32 v44, 16, v86
    v_and_b32 v45, s50, v86
    v_lshlrev_b32 v46, 16, v87
    v_and_b32 v47, s50, v87
    v_pk_mul_f32 v[40:41], v[40:41], v[8:9]
    v_pk_mul_f32 v[42:43], v[42:43], v[10:11]
    v_pk_mul_f32 v[44:45], v[44:45], v[12:13]
    v_pk_mul_f32 v[46:47], v[46:47], v[14:15]
    v_cvt_pk_bf16_f32 v84, v40, v41
    v_cvt_pk_bf16_f32 v85, v42, v43
    v_cvt_pk_bf16_f32 v86, v44, v45
    v_cvt_pk_bf16_f32 v87, v46, v47
    buffer_store_dwordx4 v[84:87], v1, s[24:27], s30 offen offset:3072 sc1
    v_lshlrev_b32 v16, 16, v88
    v_and_b32 v17, s50, v88
    v_lshlrev_b32 v18, 16, v89
    v_and_b32 v19, s50, v89
    v_lshlrev_b32 v20, 16, v90
    v_and_b32 v21, s50, v90
    v_lshlrev_b32 v22, 16, v91
    v_and_b32 v23, s50, v91
    v_pk_mul_f32 v[16:17], v[16:17], v[8:9]
    v_pk_mul_f32 v[18:19], v[18:19], v[10:11]
    v_pk_mul_f32 v[20:21], v[20:21], v[12:13]
    v_pk_mul_f32 v[22:23], v[22:23], v[14:15]
    s_mov_b32 s30, 30720
    v_cvt_pk_bf16_f32 v88, v16, v17
    v_cvt_pk_bf16_f32 v89, v18, v19
    v_cvt_pk_bf16_f32 v90, v20, v21
    v_cvt_pk_bf16_f32 v91, v22, v23
    buffer_store_dwordx4 v[88:91], v1, s[24:27], s30 offen offset:0 sc1
    v_lshlrev_b32 v40, 16, v92
    v_and_b32 v41, s50, v92
    v_lshlrev_b32 v42, 16, v93
    v_and_b32 v43, s50, v93
    v_lshlrev_b32 v44, 16, v94
    v_and_b32 v45, s50, v94
    v_lshlrev_b32 v46, 16, v95
    v_and_b32 v47, s50, v95
    v_pk_mul_f32 v[40:41], v[40:41], v[8:9]
    v_pk_mul_f32 v[42:43], v[42:43], v[10:11]
    v_pk_mul_f32 v[44:45], v[44:45], v[12:13]
    v_pk_mul_f32 v[46:47], v[46:47], v[14:15]
    v_cvt_pk_bf16_f32 v92, v40, v41
    v_cvt_pk_bf16_f32 v93, v42, v43
    v_cvt_pk_bf16_f32 v94, v44, v45
    v_cvt_pk_bf16_f32 v95, v46, v47
    buffer_store_dwordx4 v[92:95], v1, s[24:27], s30 offen offset:3072 sc1
    v_lshlrev_b32 v16, 16, v96
    v_and_b32 v17, s50, v96
    v_lshlrev_b32 v18, 16, v97
    v_and_b32 v19, s50, v97
    v_lshlrev_b32 v20, 16, v98
    v_and_b32 v21, s50, v98
    v_lshlrev_b32 v22, 16, v99
    v_and_b32 v23, s50, v99
    v_pk_mul_f32 v[16:17], v[16:17], v[8:9]
    v_pk_mul_f32 v[18:19], v[18:19], v[10:11]
    v_pk_mul_f32 v[20:21], v[20:21], v[12:13]
    v_pk_mul_f32 v[22:23], v[22:23], v[14:15]
    s_mov_b32 s30, 36864
    v_cvt_pk_bf16_f32 v96, v16, v17
    v_cvt_pk_bf16_f32 v97, v18, v19
    v_cvt_pk_bf16_f32 v98, v20, v21
    v_cvt_pk_bf16_f32 v99, v22, v23
    buffer_store_dwordx4 v[96:99], v1, s[24:27], s30 offen offset:0 sc1
    v_lshlrev_b32 v40, 16, v100
    v_and_b32 v41, s50, v100
    v_lshlrev_b32 v42, 16, v101
    v_and_b32 v43, s50, v101
    v_lshlrev_b32 v44, 16, v102
    v_and_b32 v45, s50, v102
    v_lshlrev_b32 v46, 16, v103
    v_and_b32 v47, s50, v103
    v_pk_mul_f32 v[40:41], v[40:41], v[8:9]
    v_pk_mul_f32 v[42:43], v[42:43], v[10:11]
    v_pk_mul_f32 v[44:45], v[44:45], v[12:13]
    v_pk_mul_f32 v[46:47], v[46:47], v[14:15]
    v_cvt_pk_bf16_f32 v100, v40, v41
    v_cvt_pk_bf16_f32 v101, v42, v43
    v_cvt_pk_bf16_f32 v102, v44, v45
    v_cvt_pk_bf16_f32 v103, v46, v47
    buffer_store_dwordx4 v[100:103], v1, s[24:27], s30 offen offset:3072 sc1
    v_lshlrev_b32 v16, 16, v104
    v_and_b32 v17, s50, v104
    v_lshlrev_b32 v18, 16, v105
    v_and_b32 v19, s50, v105
    v_lshlrev_b32 v20, 16, v106
    v_and_b32 v21, s50, v106
    v_lshlrev_b32 v22, 16, v107
    v_and_b32 v23, s50, v107
    v_pk_mul_f32 v[16:17], v[16:17], v[8:9]
    v_pk_mul_f32 v[18:19], v[18:19], v[10:11]
    v_pk_mul_f32 v[20:21], v[20:21], v[12:13]
    v_pk_mul_f32 v[22:23], v[22:23], v[14:15]
    s_mov_b32 s30, 43008
    v_cvt_pk_bf16_f32 v104, v16, v17
    v_cvt_pk_bf16_f32 v105, v18, v19
    v_cvt_pk_bf16_f32 v106, v20, v21
    v_cvt_pk_bf16_f32 v107, v22, v23
    buffer_store_dwordx4 v[104:107], v1, s[24:27], s30 offen offset:0 sc1
    v_lshlrev_b32 v40, 16, v108
    v_and_b32 v41, s50, v108
    v_lshlrev_b32 v42, 16, v109
    v_and_b32 v43, s50, v109
    v_lshlrev_b32 v44, 16, v110
    v_and_b32 v45, s50, v110
    v_lshlrev_b32 v46, 16, v111
    v_and_b32 v47, s50, v111
    v_pk_mul_f32 v[40:41], v[40:41], v[8:9]
    v_pk_mul_f32 v[42:43], v[42:43], v[10:11]
    v_pk_mul_f32 v[44:45], v[44:45], v[12:13]
    v_pk_mul_f32 v[46:47], v[46:47], v[14:15]
    v_cvt_pk_bf16_f32 v108, v40, v41
    v_cvt_pk_bf16_f32 v109, v42, v43
    v_cvt_pk_bf16_f32 v110, v44, v45
    v_cvt_pk_bf16_f32 v111, v46, v47
    buffer_store_dwordx4 v[108:111], v1, s[24:27], s30 offen offset:3072 sc1
    v_lshlrev_b32 v16, 16, v112
    v_and_b32 v17, s50, v112
    v_lshlrev_b32 v18, 16, v113
    v_and_b32 v19, s50, v113
    v_lshlrev_b32 v20, 16, v114
    v_and_b32 v21, s50, v114
    v_lshlrev_b32 v22, 16, v115
    v_and_b32 v23, s50, v115
    v_pk_mul_f32 v[16:17], v[16:17], v[8:9]
    v_pk_mul_f32 v[18:19], v[18:19], v[10:11]
    v_pk_mul_f32 v[20:21], v[20:21], v[12:13]
    v_pk_mul_f32 v[22:23], v[22:23], v[14:15]
    s_mov_b32 s30, 49152
    v_cvt_pk_bf16_f32 v112, v16, v17
    v_cvt_pk_bf16_f32 v113, v18, v19
    v_cvt_pk_bf16_f32 v114, v20, v21
    v_cvt_pk_bf16_f32 v115, v22, v23
    buffer_store_dwordx4 v[112:115], v1, s[24:27], s30 offen offset:0 sc1
    v_lshlrev_b32 v40, 16, v116
    v_and_b32 v41, s50, v116
    v_lshlrev_b32 v42, 16, v117
    v_and_b32 v43, s50, v117
    v_lshlrev_b32 v44, 16, v118
    v_and_b32 v45, s50, v118
    v_lshlrev_b32 v46, 16, v119
    v_and_b32 v47, s50, v119
    v_pk_mul_f32 v[40:41], v[40:41], v[8:9]
    v_pk_mul_f32 v[42:43], v[42:43], v[10:11]
    v_pk_mul_f32 v[44:45], v[44:45], v[12:13]
    v_pk_mul_f32 v[46:47], v[46:47], v[14:15]
    v_cvt_pk_bf16_f32 v116, v40, v41
    v_cvt_pk_bf16_f32 v117, v42, v43
    v_cvt_pk_bf16_f32 v118, v44, v45
    v_cvt_pk_bf16_f32 v119, v46, v47
    buffer_store_dwordx4 v[116:119], v1, s[24:27], s30 offen offset:3072 sc1
    v_lshlrev_b32 v16, 16, v120
    v_and_b32 v17, s50, v120
    v_lshlrev_b32 v18, 16, v121
    v_and_b32 v19, s50, v121
    v_lshlrev_b32 v20, 16, v122
    v_and_b32 v21, s50, v122
    v_lshlrev_b32 v22, 16, v123
    v_and_b32 v23, s50, v123
    v_pk_mul_f32 v[16:17], v[16:17], v[8:9]
    v_pk_mul_f32 v[18:19], v[18:19], v[10:11]
    v_pk_mul_f32 v[20:21], v[20:21], v[12:13]
    v_pk_mul_f32 v[22:23], v[22:23], v[14:15]
    s_mov_b32 s30, 55296
    v_cvt_pk_bf16_f32 v120, v16, v17
    v_cvt_pk_bf16_f32 v121, v18, v19
    v_cvt_pk_bf16_f32 v122, v20, v21
    v_cvt_pk_bf16_f32 v123, v22, v23
    buffer_store_dwordx4 v[120:123], v1, s[24:27], s30 offen offset:0 sc1
    v_lshlrev_b32 v40, 16, v124
    v_and_b32 v41, s50, v124
    v_lshlrev_b32 v42, 16, v125
    v_and_b32 v43, s50, v125
    v_lshlrev_b32 v44, 16, v126
    v_and_b32 v45, s50, v126
    v_lshlrev_b32 v46, 16, v127
    v_and_b32 v47, s50, v127
    v_pk_mul_f32 v[40:41], v[40:41], v[8:9]
    v_pk_mul_f32 v[42:43], v[42:43], v[10:11]
    v_pk_mul_f32 v[44:45], v[44:45], v[12:13]
    v_pk_mul_f32 v[46:47], v[46:47], v[14:15]
    v_cvt_pk_bf16_f32 v124, v40, v41
    v_cvt_pk_bf16_f32 v125, v42, v43
    v_cvt_pk_bf16_f32 v126, v44, v45
    v_cvt_pk_bf16_f32 v127, v46, v47
    buffer_store_dwordx4 v[124:127], v1, s[24:27], s30 offen offset:3072 sc1
    v_lshlrev_b32 v16, 16, v128
    v_and_b32 v17, s50, v128
    v_lshlrev_b32 v18, 16, v129
    v_and_b32 v19, s50, v129
    v_lshlrev_b32 v20, 16, v130
    v_and_b32 v21, s50, v130
    v_lshlrev_b32 v22, 16, v131
    v_and_b32 v23, s50, v131
    v_pk_mul_f32 v[16:17], v[16:17], v[8:9]
    v_pk_mul_f32 v[18:19], v[18:19], v[10:11]
    v_pk_mul_f32 v[20:21], v[20:21], v[12:13]
    v_pk_mul_f32 v[22:23], v[22:23], v[14:15]
    s_mov_b32 s30, 61440
    v_cvt_pk_bf16_f32 v128, v16, v17
    v_cvt_pk_bf16_f32 v129, v18, v19
    v_cvt_pk_bf16_f32 v130, v20, v21
    v_cvt_pk_bf16_f32 v131, v22, v23
    buffer_store_dwordx4 v[128:131], v1, s[24:27], s30 offen offset:0 sc1
    v_lshlrev_b32 v40, 16, v132
    v_and_b32 v41, s50, v132
    v_lshlrev_b32 v42, 16, v133
    v_and_b32 v43, s50, v133
    v_lshlrev_b32 v44, 16, v134
    v_and_b32 v45, s50, v134
    v_lshlrev_b32 v46, 16, v135
    v_and_b32 v47, s50, v135
    v_pk_mul_f32 v[40:41], v[40:41], v[8:9]
    v_pk_mul_f32 v[42:43], v[42:43], v[10:11]
    v_pk_mul_f32 v[44:45], v[44:45], v[12:13]
    v_pk_mul_f32 v[46:47], v[46:47], v[14:15]
    v_cvt_pk_bf16_f32 v132, v40, v41
    v_cvt_pk_bf16_f32 v133, v42, v43
    v_cvt_pk_bf16_f32 v134, v44, v45
    v_cvt_pk_bf16_f32 v135, v46, v47
    buffer_store_dwordx4 v[132:135], v1, s[24:27], s30 offen offset:3072 sc1
    v_lshlrev_b32 v16, 16, v136
    v_and_b32 v17, s50, v136
    v_lshlrev_b32 v18, 16, v137
    v_and_b32 v19, s50, v137
    v_lshlrev_b32 v20, 16, v138
    v_and_b32 v21, s50, v138
    v_lshlrev_b32 v22, 16, v139
    v_and_b32 v23, s50, v139
    v_pk_mul_f32 v[16:17], v[16:17], v[8:9]
    v_pk_mul_f32 v[18:19], v[18:19], v[10:11]
    v_pk_mul_f32 v[20:21], v[20:21], v[12:13]
    v_pk_mul_f32 v[22:23], v[22:23], v[14:15]
    s_mov_b32 s30, 67584
    v_cvt_pk_bf16_f32 v136, v16, v17
    v_cvt_pk_bf16_f32 v137, v18, v19
    v_cvt_pk_bf16_f32 v138, v20, v21
    v_cvt_pk_bf16_f32 v139, v22, v23
    buffer_store_dwordx4 v[136:139], v1, s[24:27], s30 offen offset:0 sc1
    v_lshlrev_b32 v40, 16, v140
    v_and_b32 v41, s50, v140
    v_lshlrev_b32 v42, 16, v141
    v_and_b32 v43, s50, v141
    v_lshlrev_b32 v44, 16, v142
    v_and_b32 v45, s50, v142
    v_lshlrev_b32 v46, 16, v143
    v_and_b32 v47, s50, v143
    v_pk_mul_f32 v[40:41], v[40:41], v[8:9]
    v_pk_mul_f32 v[42:43], v[42:43], v[10:11]
    v_pk_mul_f32 v[44:45], v[44:45], v[12:13]
    v_pk_mul_f32 v[46:47], v[46:47], v[14:15]
    v_cvt_pk_bf16_f32 v140, v40, v41
    v_cvt_pk_bf16_f32 v141, v42, v43
    v_cvt_pk_bf16_f32 v142, v44, v45
    v_cvt_pk_bf16_f32 v143, v46, v47
    buffer_store_dwordx4 v[140:143], v1, s[24:27], s30 offen offset:3072 sc1
    v_lshlrev_b32 v16, 16, v144
    v_and_b32 v17, s50, v144
    v_lshlrev_b32 v18, 16, v145
    v_and_b32 v19, s50, v145
    v_lshlrev_b32 v20, 16, v146
    v_and_b32 v21, s50, v146
    v_lshlrev_b32 v22, 16, v147
    v_and_b32 v23, s50, v147
    v_pk_mul_f32 v[16:17], v[16:17], v[8:9]
    v_pk_mul_f32 v[18:19], v[18:19], v[10:11]
    v_pk_mul_f32 v[20:21], v[20:21], v[12:13]
    v_pk_mul_f32 v[22:23], v[22:23], v[14:15]
    s_mov_b32 s30, 73728
    v_cvt_pk_bf16_f32 v144, v16, v17
    v_cvt_pk_bf16_f32 v145, v18, v19
    v_cvt_pk_bf16_f32 v146, v20, v21
    v_cvt_pk_bf16_f32 v147, v22, v23
    buffer_store_dwordx4 v[144:147], v1, s[24:27], s30 offen offset:0 sc1
    v_lshlrev_b32 v40, 16, v148
    v_and_b32 v41, s50, v148
    v_lshlrev_b32 v42, 16, v149
    v_and_b32 v43, s50, v149
    v_lshlrev_b32 v44, 16, v150
    v_and_b32 v45, s50, v150
    v_lshlrev_b32 v46, 16, v151
    v_and_b32 v47, s50, v151
    v_pk_mul_f32 v[40:41], v[40:41], v[8:9]
    v_pk_mul_f32 v[42:43], v[42:43], v[10:11]
    v_pk_mul_f32 v[44:45], v[44:45], v[12:13]
    v_pk_mul_f32 v[46:47], v[46:47], v[14:15]
    v_cvt_pk_bf16_f32 v148, v40, v41
    v_cvt_pk_bf16_f32 v149, v42, v43
    v_cvt_pk_bf16_f32 v150, v44, v45
    v_cvt_pk_bf16_f32 v151, v46, v47
    buffer_store_dwordx4 v[148:151], v1, s[24:27], s30 offen offset:3072 sc1
    v_lshlrev_b32 v16, 16, v152
    v_and_b32 v17, s50, v152
    v_lshlrev_b32 v18, 16, v153
    v_and_b32 v19, s50, v153
    v_lshlrev_b32 v20, 16, v154
    v_and_b32 v21, s50, v154
    v_lshlrev_b32 v22, 16, v155
    v_and_b32 v23, s50, v155
    v_pk_mul_f32 v[16:17], v[16:17], v[8:9]
    v_pk_mul_f32 v[18:19], v[18:19], v[10:11]
    v_pk_mul_f32 v[20:21], v[20:21], v[12:13]
    v_pk_mul_f32 v[22:23], v[22:23], v[14:15]
    s_mov_b32 s30, 79872
    v_cvt_pk_bf16_f32 v152, v16, v17
    v_cvt_pk_bf16_f32 v153, v18, v19
    v_cvt_pk_bf16_f32 v154, v20, v21
    v_cvt_pk_bf16_f32 v155, v22, v23
    buffer_store_dwordx4 v[152:155], v1, s[24:27], s30 offen offset:0 sc1
    v_lshlrev_b32 v40, 16, v156
    v_and_b32 v41, s50, v156
    v_lshlrev_b32 v42, 16, v157
    v_and_b32 v43, s50, v157
    v_lshlrev_b32 v44, 16, v158
    v_and_b32 v45, s50, v158
    v_lshlrev_b32 v46, 16, v159
    v_and_b32 v47, s50, v159
    v_pk_mul_f32 v[40:41], v[40:41], v[8:9]
    v_pk_mul_f32 v[42:43], v[42:43], v[10:11]
    v_pk_mul_f32 v[44:45], v[44:45], v[12:13]
    v_pk_mul_f32 v[46:47], v[46:47], v[14:15]
    v_cvt_pk_bf16_f32 v156, v40, v41
    v_cvt_pk_bf16_f32 v157, v42, v43
    v_cvt_pk_bf16_f32 v158, v44, v45
    v_cvt_pk_bf16_f32 v159, v46, v47
    buffer_store_dwordx4 v[156:159], v1, s[24:27], s30 offen offset:3072 sc1
L_stx:
L_end:
    s_endpgm
L_codeend:
.section .rodata,"a"
.p2align 6
.amdhsa_kernel standalone__channel_attn_cbam__vision_kernel
  .amdhsa_next_free_vgpr 256
  .amdhsa_next_free_sgpr 96
  .amdhsa_accum_offset 256
  .amdhsa_group_segment_fixed_size 0
  .amdhsa_kernarg_size 48
  .amdhsa_user_sgpr_count 2
  .amdhsa_user_sgpr_kernarg_segment_ptr 1
  .amdhsa_system_sgpr_workgroup_id_x 1
  .amdhsa_float_denorm_mode_32 3
.end_amdhsa_kernel
```
